```python
import torch

def _softmax(x, axis=-1):
    return torch.softmax(x, dim=axis)
def _gelu(x):
    return torch.nn.functional.gelu(x, approximate="tanh")
def _silu(x):
    return torch.nn.functional.silu(x)
def _sigmoid(x):
    return torch.sigmoid(x)
def _layernorm(x, axis=-1, eps=1e-5):
    m = x.mean(dim=axis, keepdim=True)
    v = x.var(dim=axis, keepdim=True, unbiased=False)
    return (x - m) / torch.sqrt(v + eps)
def _scatter_add(tgt, idx, src, axis=0):
    return tgt.clone().index_add_(axis, idx, src)
def _segment_sum(src, seg, n):
    out = torch.zeros((n,) + src.shape[1:], dtype=src.dtype)
    return out.index_add_(0, seg, src)
def _pad(x, pw):
    flat = tuple(v for pair in reversed(pw) for v in pair)
    return torch.nn.functional.pad(x, flat)

kernel_name = 'standalone__linear_kernel_rfa__sampling'

def setup_inputs():

    _w = (lambda a: (lambda t: t.to(torch.bfloat16) if t.is_floating_point() else t)(torch.as_tensor(a)))
    B, H, Sq, Sk, D, M = 16, 32, 8, 2048, 128, 16
    return {
        "q": _w((lambda *s: torch.randn(*s, dtype=torch.bfloat16) * 0.2)(B, H, Sq, D)),
        "k": _w((lambda *s: torch.randn(*s, dtype=torch.bfloat16) * 1.6)(B, H, Sk, D)),
        "v": _w((lambda *s: torch.randn(*s, dtype=torch.bfloat16) * 1.6)(B, H, Sk, D)),
        "omega": _w((lambda *s: torch.randn(*s, dtype=torch.bfloat16) * 1.6)(M, D)),
    }

def reference(q, k, v, omega):
    d = q.shape[-1]
    m = omega.shape[0]
    scale = float(d) ** -0.25
    qs = q * scale
    ks = k * scale
    q_proj = torch.einsum("bhsd,md->bhsm", qs, omega)
    k_proj = torch.einsum("bhsd,md->bhsm", ks, omega)
    q_sq = 0.5 * torch.einsum("bhsd,bhsd->bhs", qs, qs)[..., None]
    k_sq = 0.5 * torch.einsum("bhsd,bhsd->bhs", ks, ks)[..., None]
    inv_sqrt_m = float(m) ** -0.5
    phi_q = torch.exp(q_proj - q_sq) * inv_sqrt_m + 1e-6
    phi_k = torch.exp(k_proj - k_sq) * inv_sqrt_m + 1e-6
    kv = torch.einsum("bhsm,bhsd->bhmd", phi_k, v)
    z  = torch.einsum("bhsm->bhm", phi_k)
    num = torch.einsum("bhqm,bhmd->bhqd", phi_q, kv)
    den = torch.einsum("bhqm,bhm->bhq", phi_q, z)[..., None] + 1e-6
    return num / den
```

```asm
; @launch grid=(256,1,1) block=(512,1,1) lds=159808
.amdgcn_target "amdgcn-amd-amdhsa--gfx950"
.text
.globl standalone__linear_kernel_rfa__sampling_kernel
.p2align 8
.type standalone__linear_kernel_rfa__sampling_kernel,@function
standalone__linear_kernel_rfa__sampling_kernel:
  s_cmp_ge_u32 s2, 256
  s_cbranch_scc1 L_end
  s_load_dwordx8 s[4:11], s[0:1], 0
  s_load_dwordx2 s[12:13], s[0:1], 32
  v_lshrrev_b32 v2, 6, v0
  v_and_b32 v0, 63, v0
  v_readfirstlane_b32 s3, v2
  v_lshlrev_b32 v1, 4, v0
  v_lshrrev_b32 v3, 4, v0
  v_and_b32 v2, 15, v0
  s_and_b32 s50, s3, 3
  s_lshl_b32 s51, s50, 15
  s_lshl_b32 s52, s50, 4
  s_add_u32 s52, s52, 131072
  s_cmp_ge_u32 s3, 4
  s_cbranch_scc1 L_consumer
  s_setprio 3
  s_memrealtime s[24:25]
  v_lshlrev_b32 v12, 2, v3
  v_xor_b32 v12, v12, v2
  v_xor_b32 v13, 0, v12
  v_lshlrev_b32 v13, 4, v13
  v_lshl_add_u32 v4, v3, 8, v13
  v_xor_b32 v13, 1, v12
  v_lshlrev_b32 v13, 4, v13
  v_lshl_add_u32 v5, v3, 8, v13
  v_xor_b32 v13, 2, v12
  v_lshlrev_b32 v13, 4, v13
  v_lshl_add_u32 v6, v3, 8, v13
  v_xor_b32 v13, 3, v12
  v_lshlrev_b32 v13, 4, v13
  v_lshl_add_u32 v7, v3, 8, v13
  s_lshl_b32 s36, s2, 20
  s_lshl_b32 s38, s50, 12
  s_mov_b32 s18, 0x100000
  s_mov_b32 s19, 0x20000
  s_mov_b32 s22, 0x100000
  s_mov_b32 s23, 0x20000
  s_mov_b32 s41, 0
  v_mov_b32 v8, s52
  v_mov_b32 v9, 0
  v_mov_b32 v10, 0
  v_mov_b32 v14, 1
  ds_write_b32 v8, v9
  ds_write_b32 v8, v10 offset:4
  ds_write_b32 v8, v10 offset:8
  s_mov_b32 s43, s51
  s_mov_b32 s28, 0
  s_waitcnt lgkmcnt(0)
  s_add_u32 s16, s6, s36
  s_addc_u32 s17, s7, 0
  s_add_u32 s20, s8, s36
  s_addc_u32 s21, s9, 0
  s_mov_b32 s44, -1
  s_add_u32 m0, s43, 0
  s_and_b32 s48, s41, 15
  s_lshl_b32 s48, s48, 15
  s_and_b32 s49, s41, 16
  s_lshl_b32 s49, s49, 10
  s_or_b32 s48, s48, s49
  s_and_b32 s49, s41, 32
  s_lshl_b32 s49, s49, 14
  s_or_b32 s48, s48, s49
  s_or_b32 s39, s48, s38
  s_add_u32 s41, s41, 1
  buffer_load_dwordx4 v4, s[16:19], s39 offen offset:0 nt lds
  buffer_load_dwordx4 v5, s[16:19], s39 offen offset:1024 nt lds
  buffer_load_dwordx4 v6, s[16:19], s39 offen offset:2048 nt lds
  buffer_load_dwordx4 v7, s[16:19], s39 offen offset:3072 nt lds
  s_add_u32 m0, s43, 4096
  s_nop 0
  buffer_load_dwordx4 v1, s[20:23], s39 offen offset:0 nt lds
  s_waitcnt lgkmcnt(0)
  s_barrier
  s_waitcnt vmcnt(4)
  buffer_load_dwordx4 v1, s[20:23], s39 offen offset:1024 nt lds
  s_waitcnt vmcnt(4)
  buffer_load_dwordx4 v1, s[20:23], s39 offen offset:2048 nt lds
  s_waitcnt vmcnt(4)
  buffer_load_dwordx4 v1, s[20:23], s39 offen offset:3072 nt lds
  s_add_u32 m0, s43, 8192
  s_and_b32 s48, s41, 15
  s_lshl_b32 s48, s48, 15
  s_and_b32 s49, s41, 16
  s_lshl_b32 s49, s49, 10
  s_or_b32 s48, s48, s49
  s_and_b32 s49, s41, 32
  s_lshl_b32 s49, s49, 14
  s_or_b32 s48, s48, s49
  s_or_b32 s40, s48, s38
  s_add_u32 s41, s41, 1
  s_waitcnt vmcnt(4)
  buffer_load_dwordx4 v4, s[16:19], s40 offen offset:0 nt lds
  v_add_u32 v9, 1, v14
  ds_write_b32 v8, v9
  s_waitcnt vmcnt(4)
  buffer_load_dwordx4 v5, s[16:19], s40 offen offset:1024 nt lds
  s_waitcnt vmcnt(4)
  buffer_load_dwordx4 v6, s[16:19], s40 offen offset:2048 nt lds
  s_waitcnt vmcnt(4)
  buffer_load_dwordx4 v7, s[16:19], s40 offen offset:3072 nt lds
  s_add_u32 m0, s43, 12288
  s_nop 0
  s_waitcnt vmcnt(4)
  buffer_load_dwordx4 v1, s[20:23], s40 offen offset:0 nt lds
  v_add_u32 v9, 2, v14
  ds_write_b32 v8, v9
  s_memrealtime s[26:27]
  s_waitcnt vmcnt(4)
  buffer_load_dwordx4 v1, s[20:23], s40 offen offset:1024 nt lds
  ds_read_b32 v10, v8 offset:4
  s_waitcnt vmcnt(4)
  buffer_load_dwordx4 v1, s[20:23], s40 offen offset:2048 nt lds
  s_waitcnt vmcnt(4)
  buffer_load_dwordx4 v1, s[20:23], s40 offen offset:3072 nt lds
  s_mov_b32 s47, 1
  s_add_u32 s24, s24, 197
LL_loop:
  s_xor_b32 s43, s43, 16384
  v_add_u32 v14, 4, v14
  s_waitcnt lgkmcnt(0)
  v_readfirstlane_b32 s45, v10
  s_add_u32 s44, s44, 1
LL_chk:
  s_cmp_ge_i32 s45, s44
  s_cbranch_scc1 LL_ok
  ds_read_b32 v10, v8 offset:4
  s_waitcnt lgkmcnt(0)
  v_readfirstlane_b32 s45, v10
  s_branch LL_chk
LL_ok:
  s_sub_u32 s46, s26, s24
  s_add_u32 s24, s24, 223
  s_cmp_gt_i32 s46, 0
  s_cselect_b32 s46, 1, 0
  s_cmp_lt_u32 s47, 2
  s_cselect_b32 s46, 0, s46
  s_add_u32 s28, s28, s46
  s_cmp_ge_u32 s47, 31
  s_cselect_b32 s46, 2, s46
  s_cmp_eq_u32 s46, 1
  s_cbranch_scc1 LL_b1
  s_cmp_eq_u32 s46, 2
  s_cbranch_scc1 LL_b2
LL_b0:
  s_add_u32 m0, s43, 0
  s_and_b32 s48, s41, 15
  s_lshl_b32 s48, s48, 15
  s_and_b32 s49, s41, 16
  s_lshl_b32 s49, s49, 10
  s_or_b32 s48, s48, s49
  s_and_b32 s49, s41, 32
  s_lshl_b32 s49, s49, 14
  s_or_b32 s48, s48, s49
  s_or_b32 s39, s48, s38
  s_add_u32 s41, s41, 1
  s_waitcnt vmcnt(4)
  buffer_load_dwordx4 v4, s[16:19], s39 offen offset:0 nt lds
  v_add_u32 v9, -1, v14
  ds_write_b32 v8, v9
  s_waitcnt vmcnt(4)
  buffer_load_dwordx4 v5, s[16:19], s39 offen offset:1024 nt lds
  s_waitcnt vmcnt(4)
  buffer_load_dwordx4 v6, s[16:19], s39 offen offset:2048 nt lds
  s_waitcnt vmcnt(4)
  buffer_load_dwordx4 v7, s[16:19], s39 offen offset:3072 nt lds
  s_add_u32 m0, s43, 4096
  s_nop 0
  s_waitcnt vmcnt(4)
  buffer_load_dwordx4 v1, s[20:23], s39 offen offset:0 nt lds
  v_add_u32 v9, 0, v14
  ds_write_b32 v8, v9
  s_waitcnt vmcnt(4)
  buffer_load_dwordx4 v1, s[20:23], s39 offen offset:1024 nt lds
  s_waitcnt vmcnt(4)
  buffer_load_dwordx4 v1, s[20:23], s39 offen offset:2048 nt lds
  s_waitcnt vmcnt(4)
  buffer_load_dwordx4 v1, s[20:23], s39 offen offset:3072 nt lds
  s_add_u32 m0, s43, 8192
  s_and_b32 s48, s41, 15
  s_lshl_b32 s48, s48, 15
  s_and_b32 s49, s41, 16
  s_lshl_b32 s49, s49, 10
  s_or_b32 s48, s48, s49
  s_and_b32 s49, s41, 32
  s_lshl_b32 s49, s49, 14
  s_or_b32 s48, s48, s49
  s_or_b32 s40, s48, s38
  s_add_u32 s41, s41, 1
  s_waitcnt vmcnt(4)
  buffer_load_dwordx4 v4, s[16:19], s40 offen offset:0 nt lds
  v_add_u32 v9, 1, v14
  ds_write_b32 v8, v9
  s_waitcnt vmcnt(4)
  buffer_load_dwordx4 v5, s[16:19], s40 offen offset:1024 nt lds
  s_waitcnt vmcnt(4)
  buffer_load_dwordx4 v6, s[16:19], s40 offen offset:2048 nt lds
  s_waitcnt vmcnt(4)
  buffer_load_dwordx4 v7, s[16:19], s40 offen offset:3072 nt lds
  s_add_u32 m0, s43, 12288
  s_nop 0
  s_waitcnt vmcnt(4)
  buffer_load_dwordx4 v1, s[20:23], s40 offen offset:0 nt lds
  v_add_u32 v9, 2, v14
  ds_write_b32 v8, v9
  s_memrealtime s[26:27]
  s_waitcnt vmcnt(4)
  buffer_load_dwordx4 v1, s[20:23], s40 offen offset:1024 nt lds
  ds_read_b32 v10, v8 offset:4
  s_waitcnt vmcnt(4)
  buffer_load_dwordx4 v1, s[20:23], s40 offen offset:2048 nt lds
  s_waitcnt vmcnt(4)
  buffer_load_dwordx4 v1, s[20:23], s40 offen offset:3072 nt lds
  s_branch LL_next
LL_b1:
  s_add_u32 m0, s43, 0
  s_and_b32 s48, s41, 15
  s_lshl_b32 s48, s48, 15
  s_and_b32 s49, s41, 16
  s_lshl_b32 s49, s49, 10
  s_or_b32 s48, s48, s49
  s_and_b32 s49, s41, 32
  s_lshl_b32 s49, s49, 14
  s_or_b32 s48, s48, s49
  s_or_b32 s39, s48, s38
  s_add_u32 s41, s41, 1
  s_waitcnt vmcnt(5)
  buffer_load_dwordx4 v4, s[16:19], s39 offen offset:0 nt lds
  s_waitcnt vmcnt(5)
  buffer_load_dwordx4 v5, s[16:19], s39 offen offset:1024 nt lds
  v_add_u32 v9, -1, v14
  ds_write_b32 v8, v9
  s_waitcnt vmcnt(5)
  buffer_load_dwordx4 v6, s[16:19], s39 offen offset:2048 nt lds
  s_waitcnt vmcnt(5)
  buffer_load_dwordx4 v7, s[16:19], s39 offen offset:3072 nt lds
  s_add_u32 m0, s43, 4096
  s_nop 0
  s_waitcnt vmcnt(5)
  buffer_load_dwordx4 v1, s[20:23], s39 offen offset:0 nt lds
  s_waitcnt vmcnt(5)
  buffer_load_dwordx4 v1, s[20:23], s39 offen offset:1024 nt lds
  v_add_u32 v9, 0, v14
  ds_write_b32 v8, v9
  s_waitcnt vmcnt(5)
  buffer_load_dwordx4 v1, s[20:23], s39 offen offset:2048 nt lds
  s_waitcnt vmcnt(5)
  buffer_load_dwordx4 v1, s[20:23], s39 offen offset:3072 nt lds
  s_add_u32 m0, s43, 8192
  s_and_b32 s48, s41, 15
  s_lshl_b32 s48, s48, 15
  s_and_b32 s49, s41, 16
  s_lshl_b32 s49, s49, 10
  s_or_b32 s48, s48, s49
  s_and_b32 s49, s41, 32
  s_lshl_b32 s49, s49, 14
  s_or_b32 s48, s48, s49
  s_or_b32 s40, s48, s38
  s_add_u32 s41, s41, 1
  s_waitcnt vmcnt(5)
  buffer_load_dwordx4 v4, s[16:19], s40 offen offset:0 nt lds
  s_waitcnt vmcnt(5)
  buffer_load_dwordx4 v5, s[16:19], s40 offen offset:1024 nt lds
  v_add_u32 v9, 1, v14
  ds_write_b32 v8, v9
  s_waitcnt vmcnt(5)
  buffer_load_dwordx4 v6, s[16:19], s40 offen offset:2048 nt lds
  s_waitcnt vmcnt(5)
  buffer_load_dwordx4 v7, s[16:19], s40 offen offset:3072 nt lds
  s_add_u32 m0, s43, 12288
  s_nop 0
  s_waitcnt vmcnt(5)
  buffer_load_dwordx4 v1, s[20:23], s40 offen offset:0 nt lds
  s_memrealtime s[26:27]
  s_waitcnt vmcnt(5)
  buffer_load_dwordx4 v1, s[20:23], s40 offen offset:1024 nt lds
  v_add_u32 v9, 2, v14
  ds_write_b32 v8, v9
  ds_read_b32 v10, v8 offset:4
  s_waitcnt vmcnt(5)
  buffer_load_dwordx4 v1, s[20:23], s40 offen offset:2048 nt lds
  s_waitcnt vmcnt(5)
  buffer_load_dwordx4 v1, s[20:23], s40 offen offset:3072 nt lds
  s_branch LL_next
LL_b2:
  s_add_u32 m0, s43, 0
  s_and_b32 s48, s41, 15
  s_lshl_b32 s48, s48, 15
  s_and_b32 s49, s41, 16
  s_lshl_b32 s49, s49, 10
  s_or_b32 s48, s48, s49
  s_and_b32 s49, s41, 32
  s_lshl_b32 s49, s49, 14
  s_or_b32 s48, s48, s49
  s_or_b32 s39, s48, s38
  s_add_u32 s41, s41, 1
  s_waitcnt vmcnt(7)
  buffer_load_dwordx4 v4, s[16:19], s39 offen offset:0 nt lds
  s_waitcnt vmcnt(7)
  buffer_load_dwordx4 v5, s[16:19], s39 offen offset:1024 nt lds
  s_waitcnt vmcnt(7)
  buffer_load_dwordx4 v6, s[16:19], s39 offen offset:2048 nt lds
  s_waitcnt vmcnt(7)
  buffer_load_dwordx4 v7, s[16:19], s39 offen offset:3072 nt lds
  v_add_u32 v9, -1, v14
  ds_write_b32 v8, v9
  s_add_u32 m0, s43, 4096
  s_nop 0
  s_waitcnt vmcnt(7)
  buffer_load_dwordx4 v1, s[20:23], s39 offen offset:0 nt lds
  s_waitcnt vmcnt(7)
  buffer_load_dwordx4 v1, s[20:23], s39 offen offset:1024 nt lds
  s_waitcnt vmcnt(7)
  buffer_load_dwordx4 v1, s[20:23], s39 offen offset:2048 nt lds
  s_waitcnt vmcnt(7)
  buffer_load_dwordx4 v1, s[20:23], s39 offen offset:3072 nt lds
  v_add_u32 v9, 0, v14
  ds_write_b32 v8, v9
  s_add_u32 m0, s43, 8192
  s_and_b32 s48, s41, 15
  s_lshl_b32 s48, s48, 15
  s_and_b32 s49, s41, 16
  s_lshl_b32 s49, s49, 10
  s_or_b32 s48, s48, s49
  s_and_b32 s49, s41, 32
  s_lshl_b32 s49, s49, 14
  s_or_b32 s48, s48, s49
  s_or_b32 s40, s48, s38
  s_add_u32 s41, s41, 1
  s_waitcnt vmcnt(7)
  buffer_load_dwordx4 v4, s[16:19], s40 offen offset:0 nt lds
  s_waitcnt vmcnt(7)
  buffer_load_dwordx4 v5, s[16:19], s40 offen offset:1024 nt lds
  s_waitcnt vmcnt(7)
  buffer_load_dwordx4 v6, s[16:19], s40 offen offset:2048 nt lds
  s_waitcnt vmcnt(7)
  buffer_load_dwordx4 v7, s[16:19], s40 offen offset:3072 nt lds
  v_add_u32 v9, 1, v14
  ds_write_b32 v8, v9
  s_add_u32 m0, s43, 12288
  s_nop 0
  s_waitcnt vmcnt(7)
  buffer_load_dwordx4 v1, s[20:23], s40 offen offset:0 nt lds
  s_memrealtime s[26:27]
  s_waitcnt vmcnt(7)
  buffer_load_dwordx4 v1, s[20:23], s40 offen offset:1024 nt lds
  ds_read_b32 v10, v8 offset:4
  s_waitcnt vmcnt(7)
  buffer_load_dwordx4 v1, s[20:23], s40 offen offset:2048 nt lds
  s_waitcnt vmcnt(7)
  buffer_load_dwordx4 v1, s[20:23], s40 offen offset:3072 nt lds
  v_add_u32 v9, 2, v14
  ds_write_b32 v8, v9
LL_next:
  s_add_u32 s47, s47, 1
  s_cmp_lg_u32 s47, 32
  s_cbranch_scc1 LL_loop
  s_waitcnt vmcnt(4)
  v_add_u32 v9, 3, v14
  ds_write_b32 v8, v9
  s_waitcnt vmcnt(0)
  v_add_u32 v9, 4, v14
  ds_write_b32 v8, v9
  s_waitcnt lgkmcnt(0)
  s_barrier
  s_endpgm
L_consumer:
  s_lshl_b32 s37, s2, 12
  s_mov_b32 s26, 0x1000
  s_mov_b32 s27, 0x20000
  s_mov_b32 s30, 0x1000
  s_mov_b32 s31, 0x20000
  v_lshlrev_b32 v10, 8, v2
  v_lshl_add_u32 v10, v3, 4, v10
  s_waitcnt lgkmcnt(0)
  s_mov_b32 s28, s10
  s_mov_b32 s29, s11
  s_add_u32 s24, s4, s37
  s_addc_u32 s25, s5, 0
  buffer_load_dwordx4 v[16:19], v10, s[28:31], 0 offen offset:0
  buffer_load_dwordx4 v[20:23], v10, s[28:31], 0 offen offset:64
  buffer_load_dwordx4 v[24:27], v10, s[28:31], 0 offen offset:128
  buffer_load_dwordx4 v[28:31], v10, s[28:31], 0 offen offset:192
  buffer_load_dwordx4 v[200:203], v10, s[24:27], 0 offen offset:0
  buffer_load_dwordx4 v[204:207], v10, s[24:27], 0 offen offset:64
  buffer_load_dwordx4 v[208:211], v10, s[24:27], 0 offen offset:128
  buffer_load_dwordx4 v[212:215], v10, s[24:27], 0 offen offset:192
  v_and_b32 v14, 3, v2
  v_lshlrev_b32 v14, 10, v14
  v_lshrrev_b32 v15, 2, v2
  v_lshl_add_u32 v14, v15, 8, v14
  v_add_u32 v14, s51, v14
  v_xor_b32 v15, v3, v2
  v_xor_b32 v44, 0, v15
  v_lshl_add_u32 v4, v44, 4, v14
  v_xor_b32 v44, 4, v15
  v_lshl_add_u32 v5, v44, 4, v14
  v_xor_b32 v44, 8, v15
  v_lshl_add_u32 v6, v44, 4, v14
  v_xor_b32 v44, 12, v15
  v_lshl_add_u32 v7, v44, 4, v14
  v_add_u32 v8, s51, v1
  v_mov_b32 v9, s52
  v_mov_b32 v11, 0
  s_mov_b32 s44, 0x3edb9ada
  s_mov_b32 s45, 0x05040100
  s_mov_b32 s46, 0x07060302
  v_mov_b32 v13, 0xbe1837f0
  v_mov_b32 v32, 0x3f803f80
  v_mov_b32 v33, 0x3f803f80
  v_mov_b32 v34, 0x3f803f80
  v_mov_b32 v35, 0x3f803f80
  s_add_u32 s32, s12, s37
  s_addc_u32 s33, s13, 0
  s_mov_b32 s34, 0x1000
  s_mov_b32 s35, 0x20000
  v_mov_b32 v64, 0
  v_mov_b32 v65, 0
  v_mov_b32 v66, 0
  v_mov_b32 v67, 0
  v_mov_b32 v68, 0
  v_mov_b32 v69, 0
  v_mov_b32 v70, 0
  v_mov_b32 v71, 0
  v_mov_b32 v72, 0
  v_mov_b32 v73, 0
  v_mov_b32 v74, 0
  v_mov_b32 v75, 0
  v_mov_b32 v76, 0
  v_mov_b32 v77, 0
  v_mov_b32 v78, 0
  v_mov_b32 v79, 0
  v_mov_b32 v80, 0
  v_mov_b32 v81, 0
  v_mov_b32 v82, 0
  v_mov_b32 v83, 0
  v_mov_b32 v84, 0
  v_mov_b32 v85, 0
  v_mov_b32 v86, 0
  v_mov_b32 v87, 0
  v_mov_b32 v88, 0
  v_mov_b32 v89, 0
  v_mov_b32 v90, 0
  v_mov_b32 v91, 0
  v_mov_b32 v92, 0
  v_mov_b32 v93, 0
  v_mov_b32 v94, 0
  v_mov_b32 v95, 0
  v_mov_b32 v96, 0
  v_mov_b32 v97, 0
  v_mov_b32 v98, 0
  v_mov_b32 v99, 0
  s_mov_b32 s48, 4
  s_mov_b32 s49, 0
  s_barrier
  s_waitcnt vmcnt(0)
  v_mfma_f32_16x16x32_bf16 v[216:219], v[16:19], v[200:203], 0
  v_dot2_f32_bf16 v14, v200, v200, 0
  v_dot2_f32_bf16 v15, v201, v201, 0
  v_dot2_f32_bf16 v14, v202, v202, v14
  v_dot2_f32_bf16 v15, v203, v203, v15
  v_mfma_f32_16x16x32_bf16 v[216:219], v[20:23], v[204:207], v[216:219]
  v_dot2_f32_bf16 v14, v204, v204, v14
  v_dot2_f32_bf16 v15, v205, v205, v15
  v_dot2_f32_bf16 v14, v206, v206, v14
  v_dot2_f32_bf16 v15, v207, v207, v15
  v_mfma_f32_16x16x32_bf16 v[216:219], v[24:27], v[208:211], v[216:219]
  v_dot2_f32_bf16 v14, v208, v208, v14
  v_dot2_f32_bf16 v15, v209, v209, v15
  v_dot2_f32_bf16 v14, v210, v210, v14
  v_dot2_f32_bf16 v15, v211, v211, v15
  v_mfma_f32_16x16x32_bf16 v[216:219], v[28:31], v[212:215], v[216:219]
  v_dot2_f32_bf16 v14, v212, v212, v14
  v_dot2_f32_bf16 v15, v213, v213, v15
  v_dot2_f32_bf16 v14, v214, v214, v14
  v_dot2_f32_bf16 v15, v215, v215, v15
  s_nop 2
  v_add_f32 v14, v14, v15
  s_nop 1
  v_mfma_f32_16x16x4_f32 v[216:219], v13, v14, v[216:219]
  s_nop 7
  s_nop 1
  v_fma_f32 v60, v216, s44, -2.0
  v_fma_f32 v61, v217, s44, -2.0
  v_fma_f32 v62, v218, s44, -2.0
  v_fma_f32 v63, v219, s44, -2.0
  v_exp_f32 v60, v60
  v_exp_f32 v61, v61
  v_exp_f32 v62, v62
  v_exp_f32 v63, v63
  v_add_f32 v60, 0x358637bd, v60
  v_add_f32 v61, 0x358637bd, v61
  v_add_f32 v62, 0x358637bd, v62
  v_add_f32 v63, 0x358637bd, v63
  s_mov_b32 s47, 0
LC_loop:
  s_cmp_lg_u32 s47, 8
  s_cbranch_scc1 LC_nosw
  s_nop 7
  s_mul_i32 s53, s50, 7168
  s_add_u32 s53, s53, 131136
  v_add_u32 v124, s53, v1
  ds_write_b128 v124, v[96:99] offset:6144
  s_cmp_eq_u32 s50, 0
  s_cbranch_scc1 LC_keep0
  s_sub_u32 s54, 3, s50
  s_and_b32 s54, s54, 3
  s_lshl_b32 s54, s54, 11
  v_add_u32 v125, s54, v124
  ds_write_b128 v125, v[64:67]
  ds_write_b128 v125, v[68:71] offset:1024
  s_branch LC_kn0
LC_keep0:
  v_mov_b32 v100, v64
  v_mov_b32 v101, v65
  v_mov_b32 v102, v66
  v_mov_b32 v103, v67
  v_mov_b32 v104, v68
  v_mov_b32 v105, v69
  v_mov_b32 v106, v70
  v_mov_b32 v107, v71
LC_kn0:
  s_cmp_eq_u32 s50, 1
  s_cbranch_scc1 LC_keep1
  s_sub_u32 s54, 4, s50
  s_and_b32 s54, s54, 3
  s_lshl_b32 s54, s54, 11
  v_add_u32 v125, s54, v124
  ds_write_b128 v125, v[72:75]
  ds_write_b128 v125, v[76:79] offset:1024
  s_branch LC_kn1
LC_keep1:
  v_mov_b32 v100, v72
  v_mov_b32 v101, v73
  v_mov_b32 v102, v74
  v_mov_b32 v103, v75
  v_mov_b32 v104, v76
  v_mov_b32 v105, v77
  v_mov_b32 v106, v78
  v_mov_b32 v107, v79
LC_kn1:
  s_cmp_eq_u32 s50, 2
  s_cbranch_scc1 LC_keep2
  s_sub_u32 s54, 5, s50
  s_and_b32 s54, s54, 3
  s_lshl_b32 s54, s54, 11
  v_add_u32 v125, s54, v124
  ds_write_b128 v125, v[80:83]
  ds_write_b128 v125, v[84:87] offset:1024
  s_branch LC_kn2
LC_keep2:
  v_mov_b32 v100, v80
  v_mov_b32 v101, v81
  v_mov_b32 v102, v82
  v_mov_b32 v103, v83
  v_mov_b32 v104, v84
  v_mov_b32 v105, v85
  v_mov_b32 v106, v86
  v_mov_b32 v107, v87
LC_kn2:
  s_cmp_eq_u32 s50, 3
  s_cbranch_scc1 LC_keep3
  s_sub_u32 s54, 6, s50
  s_and_b32 s54, s54, 3
  s_lshl_b32 s54, s54, 11
  v_add_u32 v125, s54, v124
  ds_write_b128 v125, v[88:91]
  ds_write_b128 v125, v[92:95] offset:1024
  s_branch LC_kn3
LC_keep3:
  v_mov_b32 v100, v88
  v_mov_b32 v101, v89
  v_mov_b32 v102, v90
  v_mov_b32 v103, v91
  v_mov_b32 v104, v92
  v_mov_b32 v105, v93
  v_mov_b32 v106, v94
  v_mov_b32 v107, v95
LC_kn3:
  v_mov_b32 v108, v96
  v_mov_b32 v109, v97
  v_mov_b32 v110, v98
  v_mov_b32 v111, v99
  v_mov_b32 v124, 131072
  v_mov_b32 v125, 1
  ds_add_u32 v124, v125 offset:8
  s_waitcnt lgkmcnt(0)
  v_mov_b32 v64, 0
  v_mov_b32 v65, 0
  v_mov_b32 v66, 0
  v_mov_b32 v67, 0
  v_mov_b32 v68, 0
  v_mov_b32 v69, 0
  v_mov_b32 v70, 0
  v_mov_b32 v71, 0
  v_mov_b32 v72, 0
  v_mov_b32 v73, 0
  v_mov_b32 v74, 0
  v_mov_b32 v75, 0
  v_mov_b32 v76, 0
  v_mov_b32 v77, 0
  v_mov_b32 v78, 0
  v_mov_b32 v79, 0
  v_mov_b32 v80, 0
  v_mov_b32 v81, 0
  v_mov_b32 v82, 0
  v_mov_b32 v83, 0
  v_mov_b32 v84, 0
  v_mov_b32 v85, 0
  v_mov_b32 v86, 0
  v_mov_b32 v87, 0
  v_mov_b32 v88, 0
  v_mov_b32 v89, 0
  v_mov_b32 v90, 0
  v_mov_b32 v91, 0
  v_mov_b32 v92, 0
  v_mov_b32 v93, 0
  v_mov_b32 v94, 0
  v_mov_b32 v95, 0
  v_mov_b32 v96, 0
  v_mov_b32 v97, 0
  v_mov_b32 v98, 0
  v_mov_b32 v99, 0
LC_nosw:
  s_cmp_lg_u32 s47, 9
  s_cbranch_scc1 LC_nofin
  v_mov_b32 v124, 131072
LC_pollA:
  ds_read_b32 v125, v124 offset:8
  s_waitcnt lgkmcnt(0)
  v_readfirstlane_b32 s53, v125
  s_cmp_ge_u32 s53, 256
  s_cbranch_scc0 LC_pollA
  s_add_u32 s53, s50, 1
  s_and_b32 s53, s53, 3
  s_mul_i32 s53, s53, 7168
  s_add_u32 s53, s53, 131136
  v_add_u32 v125, s53, v1
  s_add_u32 s53, s50, 2
  s_and_b32 s53, s53, 3
  s_mul_i32 s53, s53, 7168
  s_add_u32 s53, s53, 131136
  v_add_u32 v126, s53, v1
  s_add_u32 s53, s50, 3
  s_and_b32 s53, s53, 3
  s_mul_i32 s53, s53, 7168
  s_add_u32 s53, s53, 131136
  v_add_u32 v127, s53, v1
  ds_read_b128 v[160:163], v125 offset:6144
  ds_read_b128 v[164:167], v126 offset:6144
  ds_read_b128 v[168:171], v127 offset:6144
  ds_read_b128 v[136:139], v125 offset:4096
  ds_read_b128 v[140:143], v126 offset:2048
  ds_read_b128 v[144:147], v127 offset:0
  ds_read_b128 v[148:151], v125 offset:5120
  ds_read_b128 v[152:155], v126 offset:3072
  ds_read_b128 v[156:159], v127 offset:1024
  s_waitcnt lgkmcnt(0)
  v_add_f32 v160, v160, v164
  v_add_f32 v161, v161, v165
  v_add_f32 v162, v162, v166
  v_add_f32 v163, v163, v167
  v_add_f32 v108, v108, v168
  v_add_f32 v109, v109, v169
  v_add_f32 v110, v110, v170
  v_add_f32 v111, v111, v171
  v_add_f32 v108, v108, v160
  v_add_f32 v109, v109, v161
  v_add_f32 v110, v110, v162
  v_add_f32 v111, v111, v163
  v_add_f32 v136, v136, v140
  v_add_f32 v137, v137, v141
  v_add_f32 v138, v138, v142
  v_add_f32 v139, v139, v143
  v_add_f32 v100, v100, v144
  v_add_f32 v101, v101, v145
  v_add_f32 v102, v102, v146
  v_add_f32 v103, v103, v147
  v_add_f32 v100, v100, v136
  v_add_f32 v101, v101, v137
  v_add_f32 v102, v102, v138
  v_add_f32 v103, v103, v139
  v_add_f32 v148, v148, v152
  v_add_f32 v149, v149, v153
  v_add_f32 v150, v150, v154
  v_add_f32 v151, v151, v155
  v_add_f32 v104, v104, v156
  v_add_f32 v105, v105, v157
  v_add_f32 v106, v106, v158
  v_add_f32 v107, v107, v159
  v_add_f32 v104, v104, v148
  v_add_f32 v105, v105, v149
  v_add_f32 v106, v106, v150
  v_add_f32 v107, v107, v151
  v_mul_f32 v44, v60, v108
  v_fma_f32 v44, v61, v109, v44
  v_fma_f32 v44, v62, v110, v44
  v_fma_f32 v44, v63, v111, v44
  v_mov_b32 v45, 1.0
  s_nop 1
  v_mfma_f32_16x16x4_f32 v[120:123], v44, v45, 0
  v_mfma_f32_16x16x4_f32 v[112:115], v60, v100, 0
  v_mfma_f32_16x16x4_f32 v[116:119], v60, v104, 0
  v_mfma_f32_16x16x4_f32 v[112:115], v61, v101, v[112:115]
  v_mfma_f32_16x16x4_f32 v[116:119], v61, v105, v[116:119]
  v_mfma_f32_16x16x4_f32 v[112:115], v62, v102, v[112:115]
  v_mfma_f32_16x16x4_f32 v[116:119], v62, v106, v[116:119]
  v_mfma_f32_16x16x4_f32 v[112:115], v63, v103, v[112:115]
  v_mfma_f32_16x16x4_f32 v[116:119], v63, v107, v[116:119]
  v_lshrrev_b32 v124, 5, v0
  v_cmp_eq_u32 vcc, 0, v124
  v_lshrrev_b32 v124, 4, v0
  v_lshlrev_b32 v124, 10, v124
  v_and_b32 v125, 15, v0
  v_lshl_add_u32 v124, v125, 4, v124
  s_lshl_b32 s56, s50, 2
  v_add_u32 v124, s56, v124
  v_add_f32 v120, 0x358637bd, v120
  v_add_f32 v121, 0x358637bd, v121
  v_add_f32 v122, 0x358637bd, v122
  v_add_f32 v123, 0x358637bd, v123
  v_rcp_f32 v120, v120
  v_rcp_f32 v121, v121
  v_rcp_f32 v122, v122
  v_rcp_f32 v123, v123
  v_mul_f32 v112, v112, v120
  v_mul_f32 v116, v116, v120
  v_mul_f32 v113, v113, v121
  v_mul_f32 v117, v117, v121
  v_mul_f32 v114, v114, v122
  v_mul_f32 v118, v118, v122
  v_mul_f32 v115, v115, v123
  v_mul_f32 v119, v119, v123
  v_cvt_pk_bf16_f32 v125, v112, v116
  v_cvt_pk_bf16_f32 v126, v113, v117
  v_cvt_pk_bf16_f32 v127, v114, v118
  v_cvt_pk_bf16_f32 v128, v115, v119
  s_and_saveexec_b64 s[58:59], vcc
  buffer_store_dword v125, v124, s[32:35], 0 offen offset:0
  buffer_store_dword v126, v124, s[32:35], 0 offen offset:256
  buffer_store_dword v127, v124, s[32:35], 0 offen offset:512
  buffer_store_dword v128, v124, s[32:35], 0 offen offset:768
  s_mov_b64 exec, s[58:59]
LC_nofin:
  s_cmp_ge_u32 s49, s48
  s_cbranch_scc1 LC_oka0
LC_polla0:
  ds_read_b32 v10, v9
  s_waitcnt lgkmcnt(0)
  v_readfirstlane_b32 s49, v10
  s_cmp_ge_u32 s49, s48
  s_cbranch_scc0 LC_polla0
LC_oka0:
  s_add_u32 s48, s48, 1
  ds_read_b128 v[136:139], v4 offset:0
  ds_read_b128 v[140:143], v5 offset:0
  ds_read_b128 v[144:147], v6 offset:0
  ds_read_b128 v[148:151], v7 offset:0
  ds_read_b128 v[152:155], v4 offset:8192
  ds_read_b128 v[156:159], v5 offset:8192
  ds_read_b128 v[160:163], v6 offset:8192
  ds_read_b128 v[164:167], v7 offset:8192
  ds_read_b128 v[168:171], v8 offset:4096
  ds_read_b128 v[172:175], v8 offset:5120
  ds_read_b128 v[176:179], v8 offset:6144
  ds_read_b128 v[180:183], v8 offset:7168
  s_waitcnt lgkmcnt(8)
  v_mfma_f32_16x16x32_bf16 v[36:39], v[136:139], v[16:19], 0
  v_dot2_f32_bf16 v14, v136, v136, 0
  v_dot2_f32_bf16 v15, v137, v137, 0
  v_dot2_f32_bf16 v14, v138, v138, v14
  v_dot2_f32_bf16 v15, v139, v139, v15
  v_mfma_f32_16x16x32_bf16 v[36:39], v[140:143], v[20:23], v[36:39]
  v_dot2_f32_bf16 v14, v140, v140, v14
  v_dot2_f32_bf16 v15, v141, v141, v15
  v_dot2_f32_bf16 v14, v142, v142, v14
  v_dot2_f32_bf16 v15, v143, v143, v15
  v_mfma_f32_16x16x32_bf16 v[36:39], v[144:147], v[24:27], v[36:39]
  v_dot2_f32_bf16 v14, v144, v144, v14
  v_dot2_f32_bf16 v15, v145, v145, v15
  v_dot2_f32_bf16 v14, v146, v146, v14
  v_dot2_f32_bf16 v15, v147, v147, v15
  v_mfma_f32_16x16x32_bf16 v[36:39], v[148:151], v[28:31], v[36:39]
  v_dot2_f32_bf16 v14, v148, v148, v14
  v_dot2_f32_bf16 v15, v149, v149, v15
  v_dot2_f32_bf16 v14, v150, v150, v14
  v_dot2_f32_bf16 v15, v151, v151, v15
  s_nop 2
  v_add_f32 v14, v14, v15
  s_nop 1
  v_mfma_f32_16x16x4_f32 v[36:39], v14, v13, v[36:39]
  s_waitcnt lgkmcnt(4)
  v_mfma_f32_16x16x32_bf16 v[40:43], v[152:155], v[16:19], 0
  v_dot2_f32_bf16 v14, v152, v152, 0
  v_dot2_f32_bf16 v15, v153, v153, 0
  v_dot2_f32_bf16 v14, v154, v154, v14
  v_dot2_f32_bf16 v15, v155, v155, v15
  v_mfma_f32_16x16x32_bf16 v[40:43], v[156:159], v[20:23], v[40:43]
  v_dot2_f32_bf16 v14, v156, v156, v14
  v_dot2_f32_bf16 v15, v157, v157, v15
  v_dot2_f32_bf16 v14, v158, v158, v14
  v_dot2_f32_bf16 v15, v159, v159, v15
  v_mfma_f32_16x16x32_bf16 v[40:43], v[160:163], v[24:27], v[40:43]
  v_dot2_f32_bf16 v14, v160, v160, v14
  v_dot2_f32_bf16 v15, v161, v161, v15
  v_dot2_f32_bf16 v14, v162, v162, v14
  v_dot2_f32_bf16 v15, v163, v163, v15
  v_mfma_f32_16x16x32_bf16 v[40:43], v[164:167], v[28:31], v[40:43]
  v_dot2_f32_bf16 v14, v164, v164, v14
  v_dot2_f32_bf16 v15, v165, v165, v15
  v_dot2_f32_bf16 v14, v166, v166, v14
  v_dot2_f32_bf16 v15, v167, v167, v15
  s_nop 2
  v_add_f32 v14, v14, v15
  s_nop 1
  v_mfma_f32_16x16x4_f32 v[40:43], v14, v13, v[40:43]
  v_fma_f32 v44, v36, s44, -2.0
  v_fma_f32 v45, v37, s44, -2.0
  v_fma_f32 v46, v38, s44, -2.0
  v_fma_f32 v47, v39, s44, -2.0
  v_exp_f32 v44, v44
  v_exp_f32 v45, v45
  v_exp_f32 v46, v46
  v_exp_f32 v47, v47
  v_add_f32 v44, 0x358637bd, v44
  v_add_f32 v45, 0x358637bd, v45
  v_add_f32 v46, 0x358637bd, v46
  v_add_f32 v47, 0x358637bd, v47
  v_cvt_pk_bf16_f32 v48, v44, v45
  v_cvt_pk_bf16_f32 v49, v46, v47
  v_fma_f32 v44, v40, s44, -2.0
  v_fma_f32 v45, v41, s44, -2.0
  v_fma_f32 v46, v42, s44, -2.0
  v_fma_f32 v47, v43, s44, -2.0
  v_exp_f32 v44, v44
  v_exp_f32 v45, v45
  v_exp_f32 v46, v46
  v_exp_f32 v47, v47
  v_add_f32 v44, 0x358637bd, v44
  v_add_f32 v45, 0x358637bd, v45
  v_add_f32 v46, 0x358637bd, v46
  v_add_f32 v47, 0x358637bd, v47
  v_cvt_pk_bf16_f32 v50, v44, v45
  v_cvt_pk_bf16_f32 v51, v46, v47
  s_cmp_ge_u32 s49, s48
  s_cbranch_scc1 LC_okb0
LC_pollb0:
  ds_read_b32 v10, v9
  s_waitcnt lgkmcnt(0)
  v_readfirstlane_b32 s49, v10
  s_cmp_ge_u32 s49, s48
  s_cbranch_scc0 LC_pollb0
LC_okb0:
  s_add_u32 s48, s48, 3
  ds_read_b128 v[184:187], v8 offset:12288
  ds_read_b128 v[188:191], v8 offset:13312
  ds_read_b128 v[192:195], v8 offset:14336
  ds_read_b128 v[196:199], v8 offset:15360
  v_add_u32 v11, 1, v11
  s_waitcnt lgkmcnt(0)
  ds_write_b32 v9, v11 offset:4
  v_perm_b32 v52, v172, v168, s45
  v_perm_b32 v53, v180, v176, s45
  v_perm_b32 v54, v188, v184, s45
  v_perm_b32 v55, v196, v192, s45
  v_perm_b32 v56, v172, v168, s46
  v_perm_b32 v57, v180, v176, s46
  v_perm_b32 v58, v188, v184, s46
  v_perm_b32 v59, v196, v192, s46
  v_mfma_f32_16x16x32_bf16 v[64:67], v[48:51], v[52:55], v[64:67]
  v_perm_b32 v52, v173, v169, s45
  v_perm_b32 v53, v181, v177, s45
  v_perm_b32 v54, v189, v185, s45
  v_perm_b32 v55, v197, v193, s45
  v_mfma_f32_16x16x32_bf16 v[68:71], v[48:51], v[56:59], v[68:71]
  v_perm_b32 v56, v173, v169, s46
  v_perm_b32 v57, v181, v177, s46
  v_perm_b32 v58, v189, v185, s46
  v_perm_b32 v59, v197, v193, s46
  v_mfma_f32_16x16x32_bf16 v[72:75], v[48:51], v[52:55], v[72:75]
  v_perm_b32 v52, v174, v170, s45
  v_perm_b32 v53, v182, v178, s45
  v_perm_b32 v54, v190, v186, s45
  v_perm_b32 v55, v198, v194, s45
  v_mfma_f32_16x16x32_bf16 v[76:79], v[48:51], v[56:59], v[76:79]
  v_perm_b32 v56, v174, v170, s46
  v_perm_b32 v57, v182, v178, s46
  v_perm_b32 v58, v190, v186, s46
  v_perm_b32 v59, v198, v194, s46
  v_mfma_f32_16x16x32_bf16 v[80:83], v[48:51], v[52:55], v[80:83]
  v_perm_b32 v52, v175, v171, s45
  v_perm_b32 v53, v183, v179, s45
  v_perm_b32 v54, v191, v187, s45
  v_perm_b32 v55, v199, v195, s45
  v_mfma_f32_16x16x32_bf16 v[84:87], v[48:51], v[56:59], v[84:87]
  v_perm_b32 v56, v175, v171, s46
  v_perm_b32 v57, v183, v179, s46
  v_perm_b32 v58, v191, v187, s46
  v_perm_b32 v59, v199, v195, s46
  v_mfma_f32_16x16x32_bf16 v[88:91], v[48:51], v[52:55], v[88:91]
  s_nop 0
  v_mfma_f32_16x16x32_bf16 v[92:95], v[48:51], v[56:59], v[92:95]
  v_mfma_f32_16x16x32_bf16 v[96:99], v[48:51], v[32:35], v[96:99]
  s_cmp_ge_u32 s49, s48
  s_cbranch_scc1 LC_oka1
LC_polla1:
  ds_read_b32 v10, v9
  s_waitcnt lgkmcnt(0)
  v_readfirstlane_b32 s49, v10
  s_cmp_ge_u32 s49, s48
  s_cbranch_scc0 LC_polla1
LC_oka1:
  s_add_u32 s48, s48, 1
  ds_read_b128 v[136:139], v4 offset:16384
  ds_read_b128 v[140:143], v5 offset:16384
  ds_read_b128 v[144:147], v6 offset:16384
  ds_read_b128 v[148:151], v7 offset:16384
  ds_read_b128 v[152:155], v4 offset:24576
  ds_read_b128 v[156:159], v5 offset:24576
  ds_read_b128 v[160:163], v6 offset:24576
  ds_read_b128 v[164:167], v7 offset:24576
  ds_read_b128 v[168:171], v8 offset:20480
  ds_read_b128 v[172:175], v8 offset:21504
  ds_read_b128 v[176:179], v8 offset:22528
  ds_read_b128 v[180:183], v8 offset:23552
  s_waitcnt lgkmcnt(8)
  v_mfma_f32_16x16x32_bf16 v[36:39], v[136:139], v[16:19], 0
  v_dot2_f32_bf16 v14, v136, v136, 0
  v_dot2_f32_bf16 v15, v137, v137, 0
  v_dot2_f32_bf16 v14, v138, v138, v14
  v_dot2_f32_bf16 v15, v139, v139, v15
  v_mfma_f32_16x16x32_bf16 v[36:39], v[140:143], v[20:23], v[36:39]
  v_dot2_f32_bf16 v14, v140, v140, v14
  v_dot2_f32_bf16 v15, v141, v141, v15
  v_dot2_f32_bf16 v14, v142, v142, v14
  v_dot2_f32_bf16 v15, v143, v143, v15
  v_mfma_f32_16x16x32_bf16 v[36:39], v[144:147], v[24:27], v[36:39]
  v_dot2_f32_bf16 v14, v144, v144, v14
  v_dot2_f32_bf16 v15, v145, v145, v15
  v_dot2_f32_bf16 v14, v146, v146, v14
  v_dot2_f32_bf16 v15, v147, v147, v15
  v_mfma_f32_16x16x32_bf16 v[36:39], v[148:151], v[28:31], v[36:39]
  v_dot2_f32_bf16 v14, v148, v148, v14
  v_dot2_f32_bf16 v15, v149, v149, v15
  v_dot2_f32_bf16 v14, v150, v150, v14
  v_dot2_f32_bf16 v15, v151, v151, v15
  s_nop 2
  v_add_f32 v14, v14, v15
  s_nop 1
  v_mfma_f32_16x16x4_f32 v[36:39], v14, v13, v[36:39]
  s_waitcnt lgkmcnt(4)
  v_mfma_f32_16x16x32_bf16 v[40:43], v[152:155], v[16:19], 0
  v_dot2_f32_bf16 v14, v152, v152, 0
  v_dot2_f32_bf16 v15, v153, v153, 0
  v_dot2_f32_bf16 v14, v154, v154, v14
  v_dot2_f32_bf16 v15, v155, v155, v15
  v_mfma_f32_16x16x32_bf16 v[40:43], v[156:159], v[20:23], v[40:43]
  v_dot2_f32_bf16 v14, v156, v156, v14
  v_dot2_f32_bf16 v15, v157, v157, v15
  v_dot2_f32_bf16 v14, v158, v158, v14
  v_dot2_f32_bf16 v15, v159, v159, v15
  v_mfma_f32_16x16x32_bf16 v[40:43], v[160:163], v[24:27], v[40:43]
  v_dot2_f32_bf16 v14, v160, v160, v14
  v_dot2_f32_bf16 v15, v161, v161, v15
  v_dot2_f32_bf16 v14, v162, v162, v14
  v_dot2_f32_bf16 v15, v163, v163, v15
  v_mfma_f32_16x16x32_bf16 v[40:43], v[164:167], v[28:31], v[40:43]
  v_dot2_f32_bf16 v14, v164, v164, v14
  v_dot2_f32_bf16 v15, v165, v165, v15
  v_dot2_f32_bf16 v14, v166, v166, v14
  v_dot2_f32_bf16 v15, v167, v167, v15
  s_nop 2
  v_add_f32 v14, v14, v15
  s_nop 1
  v_mfma_f32_16x16x4_f32 v[40:43], v14, v13, v[40:43]
  v_fma_f32 v44, v36, s44, -2.0
  v_fma_f32 v45, v37, s44, -2.0
  v_fma_f32 v46, v38, s44, -2.0
  v_fma_f32 v47, v39, s44, -2.0
  v_exp_f32 v44, v44
  v_exp_f32 v45, v45
  v_exp_f32 v46, v46
  v_exp_f32 v47, v47
  v_add_f32 v44, 0x358637bd, v44
  v_add_f32 v45, 0x358637bd, v45
  v_add_f32 v46, 0x358637bd, v46
  v_add_f32 v47, 0x358637bd, v47
  v_cvt_pk_bf16_f32 v48, v44, v45
  v_cvt_pk_bf16_f32 v49, v46, v47
  v_fma_f32 v44, v40, s44, -2.0
  v_fma_f32 v45, v41, s44, -2.0
  v_fma_f32 v46, v42, s44, -2.0
  v_fma_f32 v47, v43, s44, -2.0
  v_exp_f32 v44, v44
  v_exp_f32 v45, v45
  v_exp_f32 v46, v46
  v_exp_f32 v47, v47
  v_add_f32 v44, 0x358637bd, v44
  v_add_f32 v45, 0x358637bd, v45
  v_add_f32 v46, 0x358637bd, v46
  v_add_f32 v47, 0x358637bd, v47
  v_cvt_pk_bf16_f32 v50, v44, v45
  v_cvt_pk_bf16_f32 v51, v46, v47
  s_cmp_ge_u32 s49, s48
  s_cbranch_scc1 LC_okb1
LC_pollb1:
  ds_read_b32 v10, v9
  s_waitcnt lgkmcnt(0)
  v_readfirstlane_b32 s49, v10
  s_cmp_ge_u32 s49, s48
  s_cbranch_scc0 LC_pollb1
LC_okb1:
  s_add_u32 s48, s48, 3
  ds_read_b128 v[184:187], v8 offset:28672
  ds_read_b128 v[188:191], v8 offset:29696
  ds_read_b128 v[192:195], v8 offset:30720
  ds_read_b128 v[196:199], v8 offset:31744
  v_add_u32 v11, 1, v11
  s_waitcnt lgkmcnt(0)
  ds_write_b32 v9, v11 offset:4
  v_perm_b32 v52, v172, v168, s45
  v_perm_b32 v53, v180, v176, s45
  v_perm_b32 v54, v188, v184, s45
  v_perm_b32 v55, v196, v192, s45
  v_perm_b32 v56, v172, v168, s46
  v_perm_b32 v57, v180, v176, s46
  v_perm_b32 v58, v188, v184, s46
  v_perm_b32 v59, v196, v192, s46
  v_mfma_f32_16x16x32_bf16 v[64:67], v[48:51], v[52:55], v[64:67]
  v_perm_b32 v52, v173, v169, s45
  v_perm_b32 v53, v181, v177, s45
  v_perm_b32 v54, v189, v185, s45
  v_perm_b32 v55, v197, v193, s45
  v_mfma_f32_16x16x32_bf16 v[68:71], v[48:51], v[56:59], v[68:71]
  v_perm_b32 v56, v173, v169, s46
  v_perm_b32 v57, v181, v177, s46
  v_perm_b32 v58, v189, v185, s46
  v_perm_b32 v59, v197, v193, s46
  v_mfma_f32_16x16x32_bf16 v[72:75], v[48:51], v[52:55], v[72:75]
  v_perm_b32 v52, v174, v170, s45
  v_perm_b32 v53, v182, v178, s45
  v_perm_b32 v54, v190, v186, s45
  v_perm_b32 v55, v198, v194, s45
  v_mfma_f32_16x16x32_bf16 v[76:79], v[48:51], v[56:59], v[76:79]
  v_perm_b32 v56, v174, v170, s46
  v_perm_b32 v57, v182, v178, s46
  v_perm_b32 v58, v190, v186, s46
  v_perm_b32 v59, v198, v194, s46
  v_mfma_f32_16x16x32_bf16 v[80:83], v[48:51], v[52:55], v[80:83]
  v_perm_b32 v52, v175, v171, s45
  v_perm_b32 v53, v183, v179, s45
  v_perm_b32 v54, v191, v187, s45
  v_perm_b32 v55, v199, v195, s45
  v_mfma_f32_16x16x32_bf16 v[84:87], v[48:51], v[56:59], v[84:87]
  v_perm_b32 v56, v175, v171, s46
  v_perm_b32 v57, v183, v179, s46
  v_perm_b32 v58, v191, v187, s46
  v_perm_b32 v59, v199, v195, s46
  v_mfma_f32_16x16x32_bf16 v[88:91], v[48:51], v[52:55], v[88:91]
  s_nop 0
  v_mfma_f32_16x16x32_bf16 v[92:95], v[48:51], v[56:59], v[92:95]
  v_mfma_f32_16x16x32_bf16 v[96:99], v[48:51], v[32:35], v[96:99]
  s_add_u32 s47, s47, 1
  s_cmp_lg_u32 s47, 16
  s_cbranch_scc1 LC_loop
  ds_write_b128 v8, v[64:67] offset:0
  ds_write_b128 v8, v[68:71] offset:1024
  ds_write_b128 v8, v[72:75] offset:2048
  ds_write_b128 v8, v[76:79] offset:3072
  ds_write_b128 v8, v[80:83] offset:4096
  ds_write_b128 v8, v[84:87] offset:5120
  ds_write_b128 v8, v[88:91] offset:6144
  ds_write_b128 v8, v[92:95] offset:7168
  ds_write_b128 v8, v[96:99] offset:8192
  s_lshl_b32 s56, s50, 11
  v_add_u32 v2, s56, v1
  v_add_u32 v14, 0x10000, v2
  v_add_u32 v15, 0x10000, v1
  v_lshrrev_b32 v124, 5, v0
  v_cmp_eq_u32 vcc, 1, v124
  v_lshrrev_b32 v124, 4, v0
  v_lshlrev_b32 v124, 10, v124
  v_and_b32 v125, 15, v0
  v_lshl_add_u32 v124, v125, 4, v124
  s_lshl_b32 s56, s50, 2
  v_add_u32 v124, s56, v124
  s_waitcnt lgkmcnt(0)
  s_barrier
  ds_read_b128 v[168:171], v1 offset:8192
  ds_read_b128 v[172:175], v1 offset:40960
  ds_read_b128 v[176:179], v15 offset:8192
  ds_read_b128 v[180:183], v15 offset:40960
  ds_read_b128 v[136:139], v2 offset:0
  ds_read_b128 v[140:143], v2 offset:32768
  ds_read_b128 v[144:147], v14 offset:0
  ds_read_b128 v[148:151], v14 offset:32768
  ds_read_b128 v[152:155], v2 offset:1024
  ds_read_b128 v[156:159], v2 offset:33792
  ds_read_b128 v[160:163], v14 offset:1024
  ds_read_b128 v[164:167], v14 offset:33792
  s_waitcnt lgkmcnt(8)
  v_add_f32 v168, v168, v172
  v_add_f32 v169, v169, v173
  v_add_f32 v170, v170, v174
  v_add_f32 v171, v171, v175
  v_add_f32 v176, v176, v180
  v_add_f32 v177, v177, v181
  v_add_f32 v178, v178, v182
  v_add_f32 v179, v179, v183
  v_add_f32 v168, v168, v176
  v_add_f32 v169, v169, v177
  v_add_f32 v170, v170, v178
  v_add_f32 v171, v171, v179
  v_mul_f32 v44, v60, v168
  v_fma_f32 v44, v61, v169, v44
  v_fma_f32 v44, v62, v170, v44
  v_fma_f32 v44, v63, v171, v44
  v_mov_b32 v45, 1.0
  s_waitcnt lgkmcnt(4)
  v_add_f32 v136, v136, v140
  v_add_f32 v137, v137, v141
  v_add_f32 v138, v138, v142
  v_add_f32 v139, v139, v143
  v_mfma_f32_16x16x4_f32 v[120:123], v44, v45, 0
  v_add_f32 v144, v144, v148
  v_add_f32 v145, v145, v149
  v_add_f32 v146, v146, v150
  v_add_f32 v147, v147, v151
  v_add_f32 v136, v136, v144
  v_add_f32 v137, v137, v145
  v_add_f32 v138, v138, v146
  v_add_f32 v139, v139, v147
  s_waitcnt lgkmcnt(0)
  v_mfma_f32_16x16x4_f32 v[64:67], v60, v136, 0
  v_add_f32 v152, v152, v156
  v_add_f32 v153, v153, v157
  v_add_f32 v154, v154, v158
  v_add_f32 v155, v155, v159
  v_mfma_f32_16x16x4_f32 v[64:67], v61, v137, v[64:67]
  v_add_f32 v160, v160, v164
  v_add_f32 v161, v161, v165
  v_add_f32 v162, v162, v166
  v_add_f32 v163, v163, v167
  v_mfma_f32_16x16x4_f32 v[64:67], v62, v138, v[64:67]
  v_add_f32 v152, v152, v160
  v_add_f32 v153, v153, v161
  v_add_f32 v154, v154, v162
  v_add_f32 v155, v155, v163
  v_mfma_f32_16x16x4_f32 v[64:67], v63, v139, v[64:67]
  v_mfma_f32_16x16x4_f32 v[68:71], v60, v152, 0
  v_add_f32 v120, 0x358637bd, v120
  v_add_f32 v121, 0x358637bd, v121
  v_add_f32 v122, 0x358637bd, v122
  v_add_f32 v123, 0x358637bd, v123
  v_mfma_f32_16x16x4_f32 v[68:71], v61, v153, v[68:71]
  v_rcp_f32 v120, v120
  v_rcp_f32 v121, v121
  v_rcp_f32 v122, v122
  v_rcp_f32 v123, v123
  v_mfma_f32_16x16x4_f32 v[68:71], v62, v154, v[68:71]
  v_mfma_f32_16x16x4_f32 v[68:71], v63, v155, v[68:71]
  v_mul_f32 v64, v64, v120
  v_mul_f32 v65, v65, v121
  v_mul_f32 v66, v66, v122
  v_mul_f32 v67, v67, v123
  s_nop 5
  v_mul_f32 v68, v68, v120
  v_mul_f32 v69, v69, v121
  v_mul_f32 v70, v70, v122
  v_mul_f32 v71, v71, v123
  v_cvt_pk_bf16_f32 v125, v64, v68
  v_cvt_pk_bf16_f32 v126, v65, v69
  v_cvt_pk_bf16_f32 v127, v66, v70
  v_cvt_pk_bf16_f32 v128, v67, v71
  s_and_saveexec_b64 s[58:59], vcc
  buffer_store_dword v125, v124, s[32:35], 0 offen offset:0
  buffer_store_dword v126, v124, s[32:35], 0 offen offset:256
  buffer_store_dword v127, v124, s[32:35], 0 offen offset:512
  buffer_store_dword v128, v124, s[32:35], 0 offen offset:768
  s_mov_b64 exec, s[58:59]
L_end:
  s_endpgm
.section .rodata,"a"
.p2align 6
.amdhsa_kernel standalone__linear_kernel_rfa__sampling_kernel
  .amdhsa_next_free_vgpr 256
  .amdhsa_next_free_sgpr 96
  .amdhsa_accum_offset 256
  .amdhsa_group_segment_fixed_size 0
  .amdhsa_kernarg_size 56
  .amdhsa_user_sgpr_count 2
  .amdhsa_user_sgpr_kernarg_segment_ptr 1
  .amdhsa_system_sgpr_workgroup_id_x 1
.end_amdhsa_kernel
```
